```python
import torch

def _softmax(x, axis=-1):
    return torch.softmax(x, dim=axis)
def _gelu(x):
    return torch.nn.functional.gelu(x, approximate="tanh")
def _silu(x):
    return torch.nn.functional.silu(x)
def _sigmoid(x):
    return torch.sigmoid(x)
def _layernorm(x, axis=-1, eps=1e-5):
    m = x.mean(dim=axis, keepdim=True)
    v = x.var(dim=axis, keepdim=True, unbiased=False)
    return (x - m) / torch.sqrt(v + eps)
def _scatter_add(tgt, idx, src, axis=0):
    return tgt.clone().index_add_(axis, idx, src)
def _segment_sum(src, seg, n):
    out = torch.zeros((n,) + src.shape[1:], dtype=src.dtype)
    return out.index_add_(0, seg, src)
def _pad(x, pw):
    flat = tuple(v for pair in reversed(pw) for v in pair)
    return torch.nn.functional.pad(x, flat)

kernel_name = 'standalone__sliding_block_cached__decode'

def setup_inputs():

    _w = (lambda a: (lambda t: t.to(torch.bfloat16) if t.is_floating_point() else t)(torch.as_tensor(a)))
    B, Sq, D = 1, 1, 640
    Hq, Hkv, Sk, Dh = 32, 32, 4096, 192
    assert Hq % Hkv == 0, (Hq, Hkv)
    return {
        "x": _w((lambda *s: torch.randn(*s, dtype=torch.bfloat16) * 1.6)(B, Sq, D)),
        "k_cache": _w((lambda *s: torch.randn(*s, dtype=torch.bfloat16) * 1.6)(B, Hkv, Sk, Dh)),
        "v_cache": _w((lambda *s: torch.randn(*s, dtype=torch.bfloat16) * 0.05)(B, Hkv, Sk, Dh)),
        "wq": _w((lambda *s: torch.randn(*s, dtype=torch.bfloat16) * 1.6)(D, Hq * Dh) * (D ** -0.5)),
        "wo": _w((lambda *s: torch.randn(*s, dtype=torch.bfloat16) * 0.05)(Hq * Dh, D) * ((Hq * Dh) ** -0.5)),
    }

def reference(x, k_cache, v_cache, wq, wo):
    B, Sq, D = x.shape
    Hq, Dh = 32, 192
    Hkv, Sk = k_cache.shape[1], k_cache.shape[2]
    W = min(4096, max(256, Sk // 4))
    rep = Hq // Hkv
    q = (lambda x, *d: x.permute(*d))((x @ wq).reshape(B, Sq, Hq, Dh), 0, 2, 1, 3)
    k = (lambda x, n, axis: torch.repeat_interleave(x, n, dim=axis))(k_cache[:, :, Sk - W:, :], rep, axis=1)
    v = (lambda x, n, axis: torch.repeat_interleave(x, n, dim=axis))(v_cache[:, :, Sk - W:, :], rep, axis=1)
    scores = torch.einsum("bhqd,bhkd->bhqk", q, k) * (Dh ** -0.5)
    p = _softmax(scores, axis=-1)
    o = torch.einsum("bhqk,bhkd->bhqd", p, v)
    return (lambda x, *d: x.permute(*d))(o, 0, 2, 1, 3).reshape(B, Sq, Hq * Dh) @ wo
```

```asm
; @launch grid=(256,1,1) block=(576,1,1) lds=118784
.amdgcn_target "amdgcn-amd-amdhsa--gfx950"
.text
.globl standalone__sliding_block_cached__decode_kernel
.p2align 8
.type standalone__sliding_block_cached__decode_kernel,@function
standalone__sliding_block_cached__decode_kernel:
    s_cmp_ge_u32 s2, 256
    s_cbranch_scc1 L_end
    s_load_dwordx16 s[16:31], s[0:1], 0
    v_and_b32 v1, 63, v0
    v_lshrrev_b32 v4, 6, v0
    v_lshrrev_b32 v2, 4, v1
    v_readfirstlane_b32 s3, v4
    v_and_b32 v3, 15, v1
    s_and_b32 s4, s2, 7
    s_lshr_b32 s5, s2, 3
    s_and_b32 s6, s5, 3
    s_lshl_b32 s4, s4, 2
    s_add_u32 s4, s4, s6
    s_lshr_b32 s5, s5, 2
    s_lshl_b32 s9, s4, 3
    s_add_u32 s9, s9, s5
    s_waitcnt lgkmcnt(0)
    s_load_dword s96, s[30:31], 0xf0000
    s_mov_b32 s32, s16
    s_and_b32 s33, s17, 0xffff
    s_mov_b32 s34, 0x500
    s_mov_b32 s35, 0x20000
    s_mov_b32 s36, s18
    s_and_b32 s37, s19, 0xffff
    s_mov_b32 s38, 0x3000000
    s_mov_b32 s39, 0x20000
    s_mov_b32 s40, s20
    s_and_b32 s41, s21, 0xffff
    s_mov_b32 s42, 0x3000000
    s_mov_b32 s43, 0x20000
    s_mov_b32 s44, s22
    s_and_b32 s45, s23, 0xffff
    s_mov_b32 s46, 0x780000
    s_mov_b32 s47, 0x20000
    s_mov_b32 s48, s24
    s_and_b32 s49, s25, 0xffff
    s_mov_b32 s50, 0x780000
    s_mov_b32 s51, 0x20000
    s_mov_b32 s52, s26
    s_and_b32 s53, s27, 0xffff
    s_mov_b32 s54, 0x500
    s_mov_b32 s55, 0x20000
    s_mov_b32 s56, s28
    s_and_b32 s57, s29, 0xffff
    s_mov_b32 s58, 0x100
    s_mov_b32 s59, 0x20000
    s_mov_b32 s60, s30
    s_and_b32 s61, s31, 0xffff
    s_mov_b32 s62, 0x200000
    s_mov_b32 s63, 0x20000
    s_cmp_eq_u32 s3, 8
    s_cbranch_scc1 L_comm
    s_mul_i32 s7, s5, 160
    s_mul_i32 s8, s5, 983040
    s_mul_i32 s10, s4, 384
    s_add_u32 s8, s8, s10
    s_lshl_b32 s10, s5, 7
    s_lshl_b32 s11, s3, 4
    s_add_u32 s10, s10, s11
    s_add_u32 s10, s10, 3072
    s_mul_i32 s10, s10, 384
    s_mul_i32 s11, s4, 1572864
    s_add_u32 s10, s10, s11
    s_add_u32 s11, s10, 4096
    s_mul_i32 s12, s4, 245760
    s_add_u32 s12, s12, s7
    s_add_u32 s13, s3, 0
    s_min_u32 s13, s13, 29
    s_lshl_b32 s14, s13, 6
    v_add_u32 v6, s14, v1
    v_mul_u32_u24 v7, 2731, v6
    v_lshrrev_b32 v7, 16, v7
    v_mul_u32_u24 v8, 24, v7
    v_sub_u32 v8, v6, v8
    v_mul_u32_u24 v7, 12288, v7
    v_lshl_add_u32 v120, v8, 4, v7
    s_lshl_b32 s64, s13, 10
    s_add_u32 m0, s64, 8192
    s_nop 0
    buffer_load_dwordx4 v120, s[44:47], s8 offen nt lds
    s_add_u32 s13, s3, 8
    s_min_u32 s13, s13, 29
    s_lshl_b32 s14, s13, 6
    v_add_u32 v6, s14, v1
    v_mul_u32_u24 v7, 2731, v6
    v_lshrrev_b32 v7, 16, v7
    v_mul_u32_u24 v8, 24, v7
    v_sub_u32 v8, v6, v8
    v_mul_u32_u24 v7, 12288, v7
    v_lshl_add_u32 v121, v8, 4, v7
    s_lshl_b32 s65, s13, 10
    s_add_u32 m0, s65, 8192
    s_nop 0
    buffer_load_dwordx4 v121, s[44:47], s8 offen nt lds
    s_add_u32 s13, s3, 16
    s_min_u32 s13, s13, 29
    s_lshl_b32 s14, s13, 6
    v_add_u32 v6, s14, v1
    v_mul_u32_u24 v7, 2731, v6
    v_lshrrev_b32 v7, 16, v7
    v_mul_u32_u24 v8, 24, v7
    v_sub_u32 v8, v6, v8
    v_mul_u32_u24 v7, 12288, v7
    v_lshl_add_u32 v122, v8, 4, v7
    s_lshl_b32 s66, s13, 10
    s_add_u32 m0, s66, 8192
    s_nop 0
    buffer_load_dwordx4 v122, s[44:47], s8 offen nt lds
    s_add_u32 s13, s3, 24
    s_min_u32 s13, s13, 29
    s_lshl_b32 s14, s13, 6
    v_add_u32 v6, s14, v1
    v_mul_u32_u24 v7, 2731, v6
    v_lshrrev_b32 v7, 16, v7
    v_mul_u32_u24 v8, 24, v7
    v_sub_u32 v8, v6, v8
    v_mul_u32_u24 v7, 12288, v7
    v_lshl_add_u32 v123, v8, 4, v7
    s_lshl_b32 s67, s13, 10
    s_add_u32 m0, s67, 8192
    s_nop 0
    buffer_load_dwordx4 v123, s[44:47], s8 offen nt lds
    v_lshlrev_b32 v5, 3, v2
    buffer_load_dwordx2 v[10:11], v5, s[32:35], s7 offen offset:0
    buffer_load_dwordx2 v[12:13], v5, s[32:35], s7 offen offset:32
    buffer_load_dwordx2 v[14:15], v5, s[32:35], s7 offen offset:64
    buffer_load_dwordx2 v[16:17], v5, s[32:35], s7 offen offset:96
    buffer_load_dwordx2 v[18:19], v5, s[32:35], s7 offen offset:128
    s_barrier
    v_mul_u32_u24 v5, 384, v3
    v_lshl_add_u32 v5, v2, 4, v5
    v_lshlrev_b32 v9, 4, v1
    buffer_load_dwordx4 v[20:23], v5, s[36:39], s10 offen offset:0 nt
    buffer_load_dwordx4 v[24:27], v5, s[36:39], s10 offen offset:64 nt
    buffer_load_dwordx4 v[28:31], v5, s[36:39], s10 offen offset:128 nt
    s_lshr_b32 s14, s64, 4
    v_add_u32 v6, s14, v1
    v_mul_u32_u24 v7, 6554, v6
    v_lshrrev_b32 v7, 16, v7
    v_mul_u32_u24 v8, 10, v7
    v_sub_u32 v8, v6, v8
    v_mul_u32_u24 v7, 1280, v7
    v_lshl_add_u32 v124, v8, 4, v7
    s_lshr_b32 s14, s65, 4
    v_add_u32 v6, s14, v1
    v_mul_u32_u24 v7, 6554, v6
    v_lshrrev_b32 v7, 16, v7
    v_mul_u32_u24 v8, 10, v7
    v_sub_u32 v8, v6, v8
    v_mul_u32_u24 v7, 1280, v7
    v_lshl_add_u32 v125, v8, 4, v7
    s_lshr_b32 s14, s66, 4
    v_add_u32 v6, s14, v1
    v_mul_u32_u24 v7, 6554, v6
    v_lshrrev_b32 v7, 16, v7
    v_mul_u32_u24 v8, 10, v7
    v_sub_u32 v8, v6, v8
    v_mul_u32_u24 v7, 1280, v7
    v_lshl_add_u32 v126, v8, 4, v7
    s_lshr_b32 s14, s67, 4
    v_add_u32 v6, s14, v1
    v_mul_u32_u24 v7, 6554, v6
    v_lshrrev_b32 v7, 16, v7
    v_mul_u32_u24 v8, 10, v7
    v_sub_u32 v8, v6, v8
    v_mul_u32_u24 v7, 1280, v7
    v_lshl_add_u32 v127, v8, 4, v7
    v_lshrrev_b32 v6, 2, v3
    v_and_b32 v7, 3, v3
    v_lshl_add_u32 v6, v2, 2, v6
    v_mul_u32_u24 v110, 384, v6
    v_lshl_add_u32 v110, v7, 3, v110
    s_mul_i32 s70, s3, 6144
    s_add_u32 s70, s70, 69632
    s_add_u32 s13, s3, 8
    s_cmp_ge_u32 s13, 12
    s_cselect_b32 s14, 12, 0
    s_sub_u32 s13, s13, s14
    s_lshl_b32 s14, s3, 5
    s_lshl_b32 s15, s13, 5
    v_add_u32 v112, s14, v110
    v_add_u32 v113, s15, v110
    s_mul_i32 s68, s9, 1536
    v_lshlrev_b32 v114, 3, v3
    s_lshl_b32 s14, s3, 7
    s_lshl_b32 s15, s13, 7
    v_add_u32 v115, s15, v114
    v_add_u32 v114, s14, v114
    s_waitcnt lgkmcnt(0)
    s_add_u32 s96, s96, 1
    s_waitcnt vmcnt(3)
    s_barrier
    ds_read_b64_tr_b16 v[80:81], v112 offset:8192
    ds_read_b64_tr_b16 v[82:83], v112 offset:14336
    ds_read_b64_tr_b16 v[84:85], v112 offset:20480
    ds_read_b64_tr_b16 v[86:87], v112 offset:26624
    ds_read_b64_tr_b16 v[88:89], v112 offset:32768
    ds_read_b64_tr_b16 v[90:91], v113 offset:8192
    ds_read_b64_tr_b16 v[92:93], v113 offset:14336
    ds_read_b64_tr_b16 v[94:95], v113 offset:20480
    ds_read_b64_tr_b16 v[96:97], v113 offset:26624
    ds_read_b64_tr_b16 v[98:99], v113 offset:32768
    s_waitcnt lgkmcnt(5)
    v_mfma_f32_16x16x16_bf16 v[100:103], v[10:11], v[80:81], 0
    v_mfma_f32_16x16x16_bf16 v[100:103], v[12:13], v[82:83], v[100:103]
    v_mfma_f32_16x16x16_bf16 v[100:103], v[14:15], v[84:85], v[100:103]
    v_mfma_f32_16x16x16_bf16 v[100:103], v[16:17], v[86:87], v[100:103]
    v_mfma_f32_16x16x16_bf16 v[100:103], v[18:19], v[88:89], v[100:103]
    s_waitcnt lgkmcnt(0)
    v_mfma_f32_16x16x16_bf16 v[104:107], v[10:11], v[90:91], 0
    v_mfma_f32_16x16x16_bf16 v[104:107], v[12:13], v[92:93], v[104:107]
    v_mfma_f32_16x16x16_bf16 v[104:107], v[14:15], v[94:95], v[104:107]
    v_mfma_f32_16x16x16_bf16 v[104:107], v[16:17], v[96:97], v[104:107]
    v_mfma_f32_16x16x16_bf16 v[104:107], v[18:19], v[98:99], v[104:107]
    s_nop 7
    s_nop 3
    v_mov_b32 v101, s96
    v_mov_b32 v105, s96
    s_mov_b64 exec, 0xffff
    buffer_store_dwordx2 v[100:101], v114, s[60:63], s68 offen sc1
    buffer_store_dwordx2 v[104:105], v115, s[60:63], s68 offen sc1
    s_mov_b64 exec, -1
    s_waitcnt vmcnt(2)
    buffer_load_dwordx4 v[32:35], v5, s[36:39], s10 offen offset:192 nt
    s_waitcnt vmcnt(2)
    buffer_load_dwordx4 v[36:39], v5, s[36:39], s10 offen offset:256 nt
    s_waitcnt vmcnt(2)
    buffer_load_dwordx4 v[40:43], v5, s[36:39], s10 offen offset:320 nt
    s_waitcnt vmcnt(2)
    s_mov_b32 m0, s70
    s_nop 0
    buffer_load_dwordx4 v9, s[40:43], s10 offen offset:0 nt lds
    s_waitcnt vmcnt(2)
    s_mov_b32 m0, s70
    s_nop 0
    buffer_load_dwordx4 v9, s[40:43], s10 offen offset:1024 nt lds
    s_waitcnt vmcnt(2)
    s_mov_b32 m0, s70
    s_nop 0
    buffer_load_dwordx4 v9, s[40:43], s10 offen offset:2048 nt lds
    s_waitcnt vmcnt(2)
    s_mov_b32 m0, s70
    s_nop 0
    buffer_load_dwordx4 v9, s[40:43], s10 offen offset:3072 nt lds
    s_waitcnt vmcnt(2)
    s_add_u32 m0, s70, 4096
    s_nop 0
    buffer_load_dwordx4 v9, s[40:43], s11 offen offset:0 nt lds
    s_waitcnt vmcnt(2)
    s_add_u32 m0, s70, 4096
    s_nop 0
    buffer_load_dwordx4 v9, s[40:43], s11 offen offset:1024 nt lds
    s_barrier
    v_lshlrev_b32 v6, 4, v2
    ds_read_b128 v[44:47], v6 offset:64
    ds_read_b128 v[48:51], v6 offset:128
    ds_read_b128 v[52:55], v6 offset:192
    ds_read_b128 v[56:59], v6 offset:256
    ds_read_b128 v[60:63], v6 offset:320
    ds_read_b128 v[64:67], v6 offset:384
    s_waitcnt lgkmcnt(0)
    s_waitcnt vmcnt(6)
    v_mfma_f32_16x16x32_bf16 v[100:103], v[20:23], v[44:47], 0
    v_mfma_f32_16x16x32_bf16 v[100:103], v[24:27], v[48:51], v[100:103]
    v_mfma_f32_16x16x32_bf16 v[100:103], v[28:31], v[52:55], v[100:103]
    v_mfma_f32_16x16x32_bf16 v[100:103], v[32:35], v[56:59], v[100:103]
    v_mfma_f32_16x16x32_bf16 v[100:103], v[36:39], v[60:63], v[100:103]
    v_mfma_f32_16x16x32_bf16 v[100:103], v[40:43], v[64:67], v[100:103]
    s_waitcnt vmcnt(2)
    s_add_u32 m0, s64, 38912
    s_nop 0
    buffer_load_dwordx4 v124, s[48:51], s12 offen nt lds
    s_waitcnt vmcnt(2)
    s_add_u32 m0, s65, 38912
    s_nop 0
    buffer_load_dwordx4 v125, s[48:51], s12 offen nt lds
    s_nop 7
    s_nop 3
    s_mov_b32 s13, 0x3d93cd3a
    s_mov_b32 s14, 0x3fb8aa3b
    s_mov_b32 s15, 0xffff0000
    v_cvt_pk_bf16_f32 v104, v100, v101
    v_cvt_pk_bf16_f32 v105, v102, v103
    v_lshlrev_b32 v100, 16, v104
    v_and_b32 v101, s15, v104
    v_lshlrev_b32 v102, 16, v105
    v_and_b32 v103, s15, v105
    v_mul_f32 v100, s13, v100
    v_mul_f32 v101, s13, v101
    v_mul_f32 v102, s13, v102
    v_mul_f32 v103, s13, v103
    v_cvt_pk_bf16_f32 v104, v100, v101
    v_cvt_pk_bf16_f32 v105, v102, v103
    v_lshlrev_b32 v100, 16, v104
    v_and_b32 v101, s15, v104
    v_lshlrev_b32 v102, 16, v105
    v_and_b32 v103, s15, v105
    v_max_f32 v104, v100, v101
    v_max3_f32 v104, v104, v102, v103
    s_nop 0
    v_readlane_b32 s72, v104, 0
    v_readlane_b32 s73, v104, 16
    v_readlane_b32 s74, v104, 32
    v_readlane_b32 s75, v104, 48
    s_nop 1
    v_mov_b32 v106, s72
    v_max_f32 v106, s73, v106
    v_max_f32 v106, s74, v106
    v_max_f32 v106, s75, v106
    v_sub_f32 v100, v100, v106
    v_sub_f32 v101, v101, v106
    v_sub_f32 v102, v102, v106
    v_sub_f32 v103, v103, v106
    v_mul_f32 v100, s14, v100
    v_mul_f32 v101, s14, v101
    v_mul_f32 v102, s14, v102
    v_mul_f32 v103, s14, v103
    v_exp_f32 v100, v100
    v_exp_f32 v101, v101
    v_exp_f32 v102, v102
    v_exp_f32 v103, v103
    s_nop 0
    v_add_f32 v104, v100, v101
    v_add_f32 v105, v102, v103
    v_add_f32 v104, v104, v105
    v_cvt_pk_bf16_f32 v108, v100, v101
    v_cvt_pk_bf16_f32 v109, v102, v103
    v_readlane_b32 s72, v104, 0
    v_readlane_b32 s73, v104, 16
    v_readlane_b32 s74, v104, 32
    v_readlane_b32 s75, v104, 48
    s_nop 1
    v_mov_b32 v107, s72
    v_add_f32 v107, s73, v107
    v_add_f32 v107, s74, v107
    v_add_f32 v107, s75, v107
    s_waitcnt vmcnt(2)
    v_add_u32 v112, s70, v110
    ds_read_b64_tr_b16 v[20:21], v112 offset:0
    ds_read_b64_tr_b16 v[22:23], v112 offset:32
    ds_read_b64_tr_b16 v[24:25], v112 offset:64
    ds_read_b64_tr_b16 v[26:27], v112 offset:96
    ds_read_b64_tr_b16 v[28:29], v112 offset:128
    ds_read_b64_tr_b16 v[30:31], v112 offset:160
    ds_read_b64_tr_b16 v[32:33], v112 offset:192
    ds_read_b64_tr_b16 v[34:35], v112 offset:224
    ds_read_b64_tr_b16 v[36:37], v112 offset:256
    ds_read_b64_tr_b16 v[38:39], v112 offset:288
    ds_read_b64_tr_b16 v[40:41], v112 offset:320
    ds_read_b64_tr_b16 v[42:43], v112 offset:352
    s_waitcnt lgkmcnt(11)
    v_mfma_f32_16x16x16_bf16 v[44:47], v[108:109], v[20:21], 0
    s_waitcnt lgkmcnt(10)
    v_mfma_f32_16x16x16_bf16 v[48:51], v[108:109], v[22:23], 0
    s_waitcnt lgkmcnt(9)
    v_mfma_f32_16x16x16_bf16 v[52:55], v[108:109], v[24:25], 0
    s_waitcnt lgkmcnt(8)
    v_mfma_f32_16x16x16_bf16 v[56:59], v[108:109], v[26:27], 0
    s_waitcnt lgkmcnt(7)
    v_mfma_f32_16x16x16_bf16 v[60:63], v[108:109], v[28:29], 0
    s_waitcnt lgkmcnt(6)
    v_mfma_f32_16x16x16_bf16 v[64:67], v[108:109], v[30:31], 0
    s_waitcnt lgkmcnt(5)
    v_mfma_f32_16x16x16_bf16 v[68:71], v[108:109], v[32:33], 0
    s_waitcnt lgkmcnt(4)
    v_mfma_f32_16x16x16_bf16 v[72:75], v[108:109], v[34:35], 0
    s_waitcnt lgkmcnt(3)
    v_mfma_f32_16x16x16_bf16 v[76:79], v[108:109], v[36:37], 0
    s_waitcnt lgkmcnt(2)
    v_mfma_f32_16x16x16_bf16 v[80:83], v[108:109], v[38:39], 0
    s_waitcnt lgkmcnt(1)
    v_mfma_f32_16x16x16_bf16 v[84:87], v[108:109], v[40:41], 0
    s_waitcnt lgkmcnt(0)
    v_mfma_f32_16x16x16_bf16 v[88:91], v[108:109], v[42:43], 0
    s_add_u32 m0, s66, 38912
    s_nop 0
    buffer_load_dwordx4 v126, s[48:51], s12 offen nt lds
    s_add_u32 m0, s67, 38912
    s_nop 0
    buffer_load_dwordx4 v127, s[48:51], s12 offen nt lds
    s_mul_i32 s13, s3, 768
    v_lshlrev_b32 v6, 2, v3
    v_add_u32 v6, s13, v6
    s_lshl_b32 s13, s3, 3
    v_mov_b32 v7, s13
    s_nop 4
    s_mov_b64 exec, 0xffff
    ds_write_b32 v6, v44 offset:1024
    ds_write_b32 v6, v48 offset:1088
    ds_write_b32 v6, v52 offset:1152
    ds_write_b32 v6, v56 offset:1216
    ds_write_b32 v6, v60 offset:1280
    ds_write_b32 v6, v64 offset:1344
    ds_write_b32 v6, v68 offset:1408
    ds_write_b32 v6, v72 offset:1472
    ds_write_b32 v6, v76 offset:1536
    ds_write_b32 v6, v80 offset:1600
    ds_write_b32 v6, v84 offset:1664
    ds_write_b32 v6, v88 offset:1728
    s_mov_b64 exec, 1
    ds_write_b64 v7, v[106:107] offset:512
    s_mov_b64 exec, -1
    s_waitcnt lgkmcnt(0)
    s_barrier
    v_lshrrev_b32 v6, 2, v3
    v_and_b32 v7, 3, v3
    v_lshl_add_u32 v6, v2, 3, v6
    v_mul_u32_u24 v112, 160, v6
    v_lshl_add_u32 v112, v7, 3, v112
    s_lshl_b32 s13, s3, 5
    v_add_u32 v112, s13, v112
    v_lshlrev_b32 v6, 4, v2
    s_lshl_b32 s13, s5, 5
    s_add_u32 s13, s13, s4
    s_mul_i32 s13, s13, 640
    s_lshl_b32 s14, s3, 7
    s_add_u32 s13, s13, s14
    s_add_u32 s13, s13, 663552
    v_lshlrev_b32 v114, 3, v3
    s_waitcnt vmcnt(0)
    s_barrier
    s_cmp_ge_u32 s3, 5
    s_cbranch_scc1 L_end
    ds_read_b128 v[44:47], v6 offset:7168
    ds_read_b64_tr_b16 v[20:21], v112 offset:38912
    ds_read_b64_tr_b16 v[22:23], v112 offset:39552
    ds_read_b128 v[48:51], v6 offset:7232
    ds_read_b64_tr_b16 v[24:25], v112 offset:44032
    ds_read_b64_tr_b16 v[26:27], v112 offset:44672
    ds_read_b128 v[52:55], v6 offset:7296
    ds_read_b64_tr_b16 v[28:29], v112 offset:49152
    ds_read_b64_tr_b16 v[30:31], v112 offset:49792
    ds_read_b128 v[56:59], v6 offset:7360
    ds_read_b64_tr_b16 v[32:33], v112 offset:54272
    ds_read_b64_tr_b16 v[34:35], v112 offset:54912
    ds_read_b128 v[60:63], v6 offset:7424
    ds_read_b64_tr_b16 v[36:37], v112 offset:59392
    ds_read_b64_tr_b16 v[38:39], v112 offset:60032
    ds_read_b128 v[64:67], v6 offset:7488
    ds_read_b64_tr_b16 v[40:41], v112 offset:64512
    ds_read_b64_tr_b16 v[42:43], v112 offset:65152
    s_waitcnt lgkmcnt(15)
    v_mfma_f32_16x16x32_bf16 v[100:103], v[44:47], v[20:23], 0
    s_waitcnt lgkmcnt(12)
    v_mfma_f32_16x16x32_bf16 v[100:103], v[48:51], v[24:27], v[100:103]
    s_waitcnt lgkmcnt(9)
    v_mfma_f32_16x16x32_bf16 v[100:103], v[52:55], v[28:31], v[100:103]
    s_waitcnt lgkmcnt(6)
    v_mfma_f32_16x16x32_bf16 v[100:103], v[56:59], v[32:35], v[100:103]
    s_waitcnt lgkmcnt(3)
    v_mfma_f32_16x16x32_bf16 v[100:103], v[60:63], v[36:39], v[100:103]
    s_waitcnt lgkmcnt(0)
    v_mfma_f32_16x16x32_bf16 v[100:103], v[64:67], v[40:43], v[100:103]
    s_nop 7
    s_nop 3
    v_mov_b32 v101, s96
    s_mov_b64 exec, 0xffff
    buffer_store_dwordx2 v[100:101], v114, s[60:63], s13 offen sc1
    s_endpgm
L_comm:
    v_mov_b32 v5, 0
    s_mul_i32 s68, s4, 12288
    v_lshlrev_b32 v7, 3, v1
    s_mov_b32 s14, 0x3fb8aa3b
    s_add_u32 s72, s68, 0
    s_add_u32 s73, s68, 1536
    s_add_u32 s74, s68, 3072
    s_add_u32 s75, s68, 4608
    s_add_u32 s76, s68, 6144
    s_add_u32 s77, s68, 7680
    s_add_u32 s78, s68, 9216
    s_add_u32 s79, s68, 10752
    s_lshl_b32 s10, s5, 7
    s_add_u32 s10, s10, 3072
    s_mul_i32 s10, s10, 384
    s_mul_i32 s11, s4, 1572864
    s_add_u32 s10, s10, s11
    s_mul_i32 s12, s4, 245760
    s_add_u32 s13, s12, 245000
    buffer_load_dword v100, v5, s[40:43], s10 offen
    buffer_load_dword v101, v5, s[48:51], s12 offen
    buffer_load_dword v102, v5, s[48:51], s13 offen
    buffer_load_dword v103, v5, s[60:63], s68 offen
    buffer_load_dword v105, v5, s[52:55], 0 offen
    s_barrier
    s_waitcnt lgkmcnt(0)
    s_add_u32 s96, s96, 1
    s_barrier
    s_sleep 40
    buffer_load_dwordx2 v[10:11], v7, s[60:63], s72 offen offset:0 sc1
    buffer_load_dwordx2 v[12:13], v7, s[60:63], s73 offen offset:0 sc1
    buffer_load_dwordx2 v[14:15], v7, s[60:63], s74 offen offset:0 sc1
    buffer_load_dwordx2 v[16:17], v7, s[60:63], s75 offen offset:0 sc1
    buffer_load_dwordx2 v[18:19], v7, s[60:63], s76 offen offset:0 sc1
    buffer_load_dwordx2 v[20:21], v7, s[60:63], s77 offen offset:0 sc1
    buffer_load_dwordx2 v[22:23], v7, s[60:63], s78 offen offset:0 sc1
    buffer_load_dwordx2 v[24:25], v7, s[60:63], s79 offen offset:0 sc1
    buffer_load_dwordx2 v[26:27], v7, s[60:63], s72 offen offset:512 sc1
    buffer_load_dwordx2 v[28:29], v7, s[60:63], s73 offen offset:512 sc1
    buffer_load_dwordx2 v[30:31], v7, s[60:63], s74 offen offset:512 sc1
    buffer_load_dwordx2 v[32:33], v7, s[60:63], s75 offen offset:512 sc1
    buffer_load_dwordx2 v[34:35], v7, s[60:63], s76 offen offset:512 sc1
    buffer_load_dwordx2 v[36:37], v7, s[60:63], s77 offen offset:512 sc1
    buffer_load_dwordx2 v[38:39], v7, s[60:63], s78 offen offset:512 sc1
    buffer_load_dwordx2 v[40:41], v7, s[60:63], s79 offen offset:512 sc1
    buffer_load_dwordx2 v[42:43], v7, s[60:63], s72 offen offset:1024 sc1
    buffer_load_dwordx2 v[44:45], v7, s[60:63], s73 offen offset:1024 sc1
    buffer_load_dwordx2 v[46:47], v7, s[60:63], s74 offen offset:1024 sc1
    buffer_load_dwordx2 v[48:49], v7, s[60:63], s75 offen offset:1024 sc1
    buffer_load_dwordx2 v[50:51], v7, s[60:63], s76 offen offset:1024 sc1
    buffer_load_dwordx2 v[52:53], v7, s[60:63], s77 offen offset:1024 sc1
    buffer_load_dwordx2 v[54:55], v7, s[60:63], s78 offen offset:1024 sc1
    buffer_load_dwordx2 v[56:57], v7, s[60:63], s79 offen offset:1024 sc1
    s_mov_b32 s69, 0
L_pq_tops:
    s_waitcnt vmcnt(0)
    v_xor_b32 v8, s96, v11
    v_xor_b32 v9, s96, v13
    v_or_b32 v8, v8, v9
    v_xor_b32 v9, s96, v15
    v_or_b32 v8, v8, v9
    v_xor_b32 v9, s96, v17
    v_or_b32 v8, v8, v9
    v_xor_b32 v9, s96, v19
    v_or_b32 v8, v8, v9
    v_xor_b32 v9, s96, v21
    v_or_b32 v8, v8, v9
    v_xor_b32 v9, s96, v23
    v_or_b32 v8, v8, v9
    v_xor_b32 v9, s96, v25
    v_or_b32 v8, v8, v9
    v_xor_b32 v9, s96, v27
    v_or_b32 v8, v8, v9
    v_xor_b32 v9, s96, v29
    v_or_b32 v8, v8, v9
    v_xor_b32 v9, s96, v31
    v_or_b32 v8, v8, v9
    v_xor_b32 v9, s96, v33
    v_or_b32 v8, v8, v9
    v_xor_b32 v9, s96, v35
    v_or_b32 v8, v8, v9
    v_xor_b32 v9, s96, v37
    v_or_b32 v8, v8, v9
    v_xor_b32 v9, s96, v39
    v_or_b32 v8, v8, v9
    v_xor_b32 v9, s96, v41
    v_or_b32 v8, v8, v9
    v_xor_b32 v9, s96, v43
    v_or_b32 v8, v8, v9
    v_xor_b32 v9, s96, v45
    v_or_b32 v8, v8, v9
    v_xor_b32 v9, s96, v47
    v_or_b32 v8, v8, v9
    v_xor_b32 v9, s96, v49
    v_or_b32 v8, v8, v9
    v_xor_b32 v9, s96, v51
    v_or_b32 v8, v8, v9
    v_xor_b32 v9, s96, v53
    v_or_b32 v8, v8, v9
    v_xor_b32 v9, s96, v55
    v_or_b32 v8, v8, v9
    v_xor_b32 v9, s96, v57
    v_or_b32 v8, v8, v9
    v_cmp_ne_u32 vcc, 0, v8
    s_cbranch_vccz L_pq_ok0
    s_add_u32 s69, s69, 1
    s_sleep 2
    buffer_load_dwordx2 v[10:11], v7, s[60:63], s72 offen offset:0 sc1
    buffer_load_dwordx2 v[12:13], v7, s[60:63], s73 offen offset:0 sc1
    buffer_load_dwordx2 v[14:15], v7, s[60:63], s74 offen offset:0 sc1
    buffer_load_dwordx2 v[16:17], v7, s[60:63], s75 offen offset:0 sc1
    buffer_load_dwordx2 v[18:19], v7, s[60:63], s76 offen offset:0 sc1
    buffer_load_dwordx2 v[20:21], v7, s[60:63], s77 offen offset:0 sc1
    buffer_load_dwordx2 v[22:23], v7, s[60:63], s78 offen offset:0 sc1
    buffer_load_dwordx2 v[24:25], v7, s[60:63], s79 offen offset:0 sc1
    buffer_load_dwordx2 v[26:27], v7, s[60:63], s72 offen offset:512 sc1
    buffer_load_dwordx2 v[28:29], v7, s[60:63], s73 offen offset:512 sc1
    buffer_load_dwordx2 v[30:31], v7, s[60:63], s74 offen offset:512 sc1
    buffer_load_dwordx2 v[32:33], v7, s[60:63], s75 offen offset:512 sc1
    buffer_load_dwordx2 v[34:35], v7, s[60:63], s76 offen offset:512 sc1
    buffer_load_dwordx2 v[36:37], v7, s[60:63], s77 offen offset:512 sc1
    buffer_load_dwordx2 v[38:39], v7, s[60:63], s78 offen offset:512 sc1
    buffer_load_dwordx2 v[40:41], v7, s[60:63], s79 offen offset:512 sc1
    buffer_load_dwordx2 v[42:43], v7, s[60:63], s72 offen offset:1024 sc1
    buffer_load_dwordx2 v[44:45], v7, s[60:63], s73 offen offset:1024 sc1
    buffer_load_dwordx2 v[46:47], v7, s[60:63], s74 offen offset:1024 sc1
    buffer_load_dwordx2 v[48:49], v7, s[60:63], s75 offen offset:1024 sc1
    buffer_load_dwordx2 v[50:51], v7, s[60:63], s76 offen offset:1024 sc1
    buffer_load_dwordx2 v[52:53], v7, s[60:63], s77 offen offset:1024 sc1
    buffer_load_dwordx2 v[54:55], v7, s[60:63], s78 offen offset:1024 sc1
    buffer_load_dwordx2 v[56:57], v7, s[60:63], s79 offen offset:1024 sc1
    s_cmp_lt_u32 s69, 100000
    s_cbranch_scc1 L_pq_tops
    s_waitcnt vmcnt(0)
L_pq_ok0:
    v_add_f32 v10, v10, v12
    v_add_f32 v10, v10, v14
    v_add_f32 v10, v10, v16
    v_add_f32 v10, v10, v18
    v_add_f32 v10, v10, v20
    v_add_f32 v10, v10, v22
    v_add_f32 v10, v10, v24
    v_cvt_pk_bf16_f32 v10, v10, v10
    v_add_f32 v26, v26, v28
    v_add_f32 v26, v26, v30
    v_add_f32 v26, v26, v32
    v_add_f32 v26, v26, v34
    v_add_f32 v26, v26, v36
    v_add_f32 v26, v26, v38
    v_add_f32 v26, v26, v40
    v_cvt_pk_bf16_f32 v26, v26, v26
    v_add_f32 v42, v42, v44
    v_add_f32 v42, v42, v46
    v_add_f32 v42, v42, v48
    v_add_f32 v42, v42, v50
    v_add_f32 v42, v42, v52
    v_add_f32 v42, v42, v54
    v_add_f32 v42, v42, v56
    v_cvt_pk_bf16_f32 v42, v42, v42
    v_lshlrev_b32 v6, 1, v1
    ds_write_b16 v6, v10 offset:64
    ds_write_b16 v6, v26 offset:192
    ds_write_b16 v6, v42 offset:320
L_pq_done:
    s_waitcnt lgkmcnt(0)
    s_barrier
    v_lshlrev_b32 v7, 4, v1
    s_lshl_b32 s13, s9, 10
    s_add_u32 s13, s13, 393216
    s_lshl_b32 s15, s9, 4
    s_add_u32 s15, s15, 655360
    s_lshl_b32 s88, s4, 13
    s_add_u32 s88, s88, 393216
    s_add_u32 s89, s88, 4096
    s_lshl_b32 s68, s4, 7
    s_add_u32 s68, s68, 655360
    v_and_b32 v8, 7, v1
    v_lshlrev_b32 v8, 4, v8
    v_lshlrev_b32 v9, 2, v1
    v_mov_b32 v6, 0
    s_waitcnt vmcnt(0)
    s_barrier
    ds_read_b128 v[120:123], v6 offset:512
    ds_read_b128 v[124:127], v6 offset:528
    ds_read_b128 v[128:131], v6 offset:544
    ds_read_b128 v[132:135], v6 offset:560
    ds_read_b32 v10, v9 offset:1024
    ds_read_b32 v11, v9 offset:1280
    ds_read_b32 v12, v9 offset:1536
    ds_read_b32 v13, v9 offset:1792
    ds_read_b32 v14, v9 offset:2048
    ds_read_b32 v15, v9 offset:2304
    ds_read_b32 v16, v9 offset:2560
    ds_read_b32 v17, v9 offset:2816
    ds_read_b32 v18, v9 offset:3072
    ds_read_b32 v19, v9 offset:3328
    ds_read_b32 v20, v9 offset:3584
    ds_read_b32 v21, v9 offset:3840
    ds_read_b32 v22, v9 offset:4096
    ds_read_b32 v23, v9 offset:4352
    ds_read_b32 v24, v9 offset:4608
    ds_read_b32 v25, v9 offset:4864
    ds_read_b32 v26, v9 offset:5120
    ds_read_b32 v27, v9 offset:5376
    ds_read_b32 v28, v9 offset:5632
    ds_read_b32 v29, v9 offset:5888
    ds_read_b32 v30, v9 offset:6144
    ds_read_b32 v31, v9 offset:6400
    ds_read_b32 v32, v9 offset:6656
    ds_read_b32 v33, v9 offset:6912
    s_waitcnt lgkmcnt(15)
    v_max_f32 v140, v120, v122
    v_max_f32 v140, v140, v124
    v_max_f32 v140, v140, v126
    v_max_f32 v140, v140, v128
    v_max_f32 v140, v140, v130
    v_max_f32 v140, v140, v132
    v_max_f32 v140, v140, v134
    v_sub_f32 v120, v120, v140
    v_sub_f32 v122, v122, v140
    v_sub_f32 v124, v124, v140
    v_sub_f32 v126, v126, v140
    v_sub_f32 v128, v128, v140
    v_sub_f32 v130, v130, v140
    v_sub_f32 v132, v132, v140
    v_sub_f32 v134, v134, v140
    v_mul_f32 v120, s14, v120
    v_mul_f32 v122, s14, v122
    v_mul_f32 v124, s14, v124
    v_mul_f32 v126, s14, v126
    v_mul_f32 v128, s14, v128
    v_mul_f32 v130, s14, v130
    v_mul_f32 v132, s14, v132
    v_mul_f32 v134, s14, v134
    v_exp_f32 v120, v120
    v_exp_f32 v122, v122
    v_exp_f32 v124, v124
    v_exp_f32 v126, v126
    v_exp_f32 v128, v128
    v_exp_f32 v130, v130
    v_exp_f32 v132, v132
    v_exp_f32 v134, v134
    s_nop 0
    v_mul_f32 v141, v120, v121
    v_fmac_f32 v141, v122, v123
    v_fmac_f32 v141, v124, v125
    v_fmac_f32 v141, v126, v127
    v_fmac_f32 v141, v128, v129
    v_fmac_f32 v141, v130, v131
    v_fmac_f32 v141, v132, v133
    v_fmac_f32 v141, v134, v135
    s_waitcnt lgkmcnt(0)
    v_mul_f32 v144, v120, v10
    v_fmac_f32 v144, v122, v13
    v_fmac_f32 v144, v124, v16
    v_fmac_f32 v144, v126, v19
    v_fmac_f32 v144, v128, v22
    v_fmac_f32 v144, v130, v25
    v_fmac_f32 v144, v132, v28
    v_fmac_f32 v144, v134, v31
    v_mul_f32 v145, v120, v11
    v_fmac_f32 v145, v122, v14
    v_fmac_f32 v145, v124, v17
    v_fmac_f32 v145, v126, v20
    v_fmac_f32 v145, v128, v23
    v_fmac_f32 v145, v130, v26
    v_fmac_f32 v145, v132, v29
    v_fmac_f32 v145, v134, v32
    v_mul_f32 v146, v120, v12
    v_fmac_f32 v146, v122, v15
    v_fmac_f32 v146, v124, v18
    v_fmac_f32 v146, v126, v21
    v_fmac_f32 v146, v128, v24
    v_fmac_f32 v146, v130, v27
    v_fmac_f32 v146, v132, v30
    v_fmac_f32 v146, v134, v33
    v_mov_b32 v147, s96
    v_mov_b32 v142, s96
    v_mov_b32 v143, s96
    buffer_store_dwordx4 v[144:147], v7, s[60:63], s13 offen sc1
    s_mov_b64 exec, 1
    buffer_store_dwordx4 v[140:143], v5, s[60:63], s15 offen sc1
    s_mov_b64 exec, -1
    s_sleep 8
    buffer_load_dwordx4 v[10:13], v7, s[60:63], s88 offen offset:0 sc1
    buffer_load_dwordx4 v[14:17], v7, s[60:63], s88 offen offset:1024 sc1
    buffer_load_dwordx4 v[18:21], v7, s[60:63], s88 offen offset:2048 sc1
    buffer_load_dwordx4 v[22:25], v7, s[60:63], s88 offen offset:3072 sc1
    buffer_load_dwordx4 v[26:29], v7, s[60:63], s89 offen offset:0 sc1
    buffer_load_dwordx4 v[30:33], v7, s[60:63], s89 offen offset:1024 sc1
    buffer_load_dwordx4 v[34:37], v7, s[60:63], s89 offen offset:2048 sc1
    buffer_load_dwordx4 v[38:41], v7, s[60:63], s89 offen offset:3072 sc1
    buffer_load_dwordx4 v[42:45], v8, s[60:63], s68 offen sc1
    s_sleep 24
    buffer_load_dwordx4 v[46:49], v7, s[60:63], s88 offen offset:0 sc1
    buffer_load_dwordx4 v[50:53], v7, s[60:63], s88 offen offset:1024 sc1
    buffer_load_dwordx4 v[54:57], v7, s[60:63], s88 offen offset:2048 sc1
    buffer_load_dwordx4 v[58:61], v7, s[60:63], s88 offen offset:3072 sc1
    buffer_load_dwordx4 v[62:65], v7, s[60:63], s89 offen offset:0 sc1
    buffer_load_dwordx4 v[66:69], v7, s[60:63], s89 offen offset:1024 sc1
    buffer_load_dwordx4 v[70:73], v7, s[60:63], s89 offen offset:2048 sc1
    buffer_load_dwordx4 v[74:77], v7, s[60:63], s89 offen offset:3072 sc1
    buffer_load_dwordx4 v[78:81], v8, s[60:63], s68 offen sc1
    s_mov_b32 s69, 0
L_po_tops:
    s_waitcnt vmcnt(9)
    v_xor_b32 v150, s96, v44
    v_xor_b32 v151, s96, v13
    v_or_b32 v150, v150, v151
    v_xor_b32 v151, s96, v17
    v_or_b32 v150, v150, v151
    v_xor_b32 v151, s96, v21
    v_or_b32 v150, v150, v151
    v_xor_b32 v151, s96, v25
    v_or_b32 v150, v150, v151
    v_xor_b32 v151, s96, v29
    v_or_b32 v150, v150, v151
    v_xor_b32 v151, s96, v33
    v_or_b32 v150, v150, v151
    v_xor_b32 v151, s96, v37
    v_or_b32 v150, v150, v151
    v_xor_b32 v151, s96, v41
    v_or_b32 v150, v150, v151
    v_cmp_ne_u32 vcc, 0, v150
    s_cbranch_vccz L_po_ok0
    s_add_u32 s69, s69, 1
    buffer_load_dwordx4 v[10:13], v7, s[60:63], s88 offen offset:0 sc1
    buffer_load_dwordx4 v[14:17], v7, s[60:63], s88 offen offset:1024 sc1
    buffer_load_dwordx4 v[18:21], v7, s[60:63], s88 offen offset:2048 sc1
    buffer_load_dwordx4 v[22:25], v7, s[60:63], s88 offen offset:3072 sc1
    buffer_load_dwordx4 v[26:29], v7, s[60:63], s89 offen offset:0 sc1
    buffer_load_dwordx4 v[30:33], v7, s[60:63], s89 offen offset:1024 sc1
    buffer_load_dwordx4 v[34:37], v7, s[60:63], s89 offen offset:2048 sc1
    buffer_load_dwordx4 v[38:41], v7, s[60:63], s89 offen offset:3072 sc1
    buffer_load_dwordx4 v[42:45], v8, s[60:63], s68 offen sc1
    s_waitcnt vmcnt(9)
    v_xor_b32 v150, s96, v80
    v_xor_b32 v151, s96, v49
    v_or_b32 v150, v150, v151
    v_xor_b32 v151, s96, v53
    v_or_b32 v150, v150, v151
    v_xor_b32 v151, s96, v57
    v_or_b32 v150, v150, v151
    v_xor_b32 v151, s96, v61
    v_or_b32 v150, v150, v151
    v_xor_b32 v151, s96, v65
    v_or_b32 v150, v150, v151
    v_xor_b32 v151, s96, v69
    v_or_b32 v150, v150, v151
    v_xor_b32 v151, s96, v73
    v_or_b32 v150, v150, v151
    v_xor_b32 v151, s96, v77
    v_or_b32 v150, v150, v151
    v_cmp_ne_u32 vcc, 0, v150
    s_cbranch_vccz L_po_ok1
    s_add_u32 s69, s69, 1
    buffer_load_dwordx4 v[46:49], v7, s[60:63], s88 offen offset:0 sc1
    buffer_load_dwordx4 v[50:53], v7, s[60:63], s88 offen offset:1024 sc1
    buffer_load_dwordx4 v[54:57], v7, s[60:63], s88 offen offset:2048 sc1
    buffer_load_dwordx4 v[58:61], v7, s[60:63], s88 offen offset:3072 sc1
    buffer_load_dwordx4 v[62:65], v7, s[60:63], s89 offen offset:0 sc1
    buffer_load_dwordx4 v[66:69], v7, s[60:63], s89 offen offset:1024 sc1
    buffer_load_dwordx4 v[70:73], v7, s[60:63], s89 offen offset:2048 sc1
    buffer_load_dwordx4 v[74:77], v7, s[60:63], s89 offen offset:3072 sc1
    buffer_load_dwordx4 v[78:81], v8, s[60:63], s68 offen sc1
    s_cmp_lt_u32 s69, 100000
    s_cbranch_scc1 L_po_tops
    s_waitcnt vmcnt(0)
L_po_ok0:
    v_readlane_b32 s72, v42, 0
    v_readlane_b32 s80, v43, 0
    v_readlane_b32 s73, v42, 1
    v_readlane_b32 s81, v43, 1
    v_readlane_b32 s74, v42, 2
    v_readlane_b32 s82, v43, 2
    v_readlane_b32 s75, v42, 3
    v_readlane_b32 s83, v43, 3
    v_readlane_b32 s76, v42, 4
    v_readlane_b32 s84, v43, 4
    v_readlane_b32 s77, v42, 5
    v_readlane_b32 s85, v43, 5
    v_readlane_b32 s78, v42, 6
    v_readlane_b32 s86, v43, 6
    v_readlane_b32 s79, v42, 7
    v_readlane_b32 s87, v43, 7
    s_nop 1
    v_mov_b32 v128, s72
    v_max_f32 v128, s73, v128
    v_max_f32 v128, s74, v128
    v_max_f32 v128, s75, v128
    v_max_f32 v128, s76, v128
    v_max_f32 v128, s77, v128
    v_max_f32 v128, s78, v128
    v_max_f32 v128, s79, v128
    v_sub_f32 v120, s72, v128
    v_sub_f32 v121, s73, v128
    v_sub_f32 v122, s74, v128
    v_sub_f32 v123, s75, v128
    v_sub_f32 v124, s76, v128
    v_sub_f32 v125, s77, v128
    v_sub_f32 v126, s78, v128
    v_sub_f32 v127, s79, v128
    v_mul_f32 v120, s14, v120
    v_mul_f32 v121, s14, v121
    v_mul_f32 v122, s14, v122
    v_mul_f32 v123, s14, v123
    v_mul_f32 v124, s14, v124
    v_mul_f32 v125, s14, v125
    v_mul_f32 v126, s14, v126
    v_mul_f32 v127, s14, v127
    v_exp_f32 v120, v120
    v_exp_f32 v121, v121
    v_exp_f32 v122, v122
    v_exp_f32 v123, v123
    v_exp_f32 v124, v124
    v_exp_f32 v125, v125
    v_exp_f32 v126, v126
    v_exp_f32 v127, v127
    s_nop 0
    v_mul_f32 v129, s80, v120
    v_fmac_f32 v129, s81, v121
    v_fmac_f32 v129, s82, v122
    v_fmac_f32 v129, s83, v123
    v_fmac_f32 v129, s84, v124
    v_fmac_f32 v129, s85, v125
    v_fmac_f32 v129, s86, v126
    v_fmac_f32 v129, s87, v127
    v_rcp_f32 v129, v129
    v_mul_f32 v130, v120, v10
    v_fmac_f32 v130, v121, v14
    v_fmac_f32 v130, v122, v18
    v_fmac_f32 v130, v123, v22
    v_fmac_f32 v130, v124, v26
    v_fmac_f32 v130, v125, v30
    v_fmac_f32 v130, v126, v34
    v_fmac_f32 v130, v127, v38
    v_mul_f32 v131, v120, v11
    v_fmac_f32 v131, v121, v15
    v_fmac_f32 v131, v122, v19
    v_fmac_f32 v131, v123, v23
    v_fmac_f32 v131, v124, v27
    v_fmac_f32 v131, v125, v31
    v_fmac_f32 v131, v126, v35
    v_fmac_f32 v131, v127, v39
    v_mul_f32 v132, v120, v12
    v_fmac_f32 v132, v121, v16
    v_fmac_f32 v132, v122, v20
    v_fmac_f32 v132, v123, v24
    v_fmac_f32 v132, v124, v28
    v_fmac_f32 v132, v125, v32
    v_fmac_f32 v132, v126, v36
    v_fmac_f32 v132, v127, v40
    v_mul_f32 v130, v130, v129
    v_cvt_pk_bf16_f32 v130, v130, v130
    v_mul_f32 v131, v131, v129
    v_cvt_pk_bf16_f32 v131, v131, v131
    v_mul_f32 v132, v132, v129
    v_cvt_pk_bf16_f32 v132, v132, v132
    v_lshlrev_b32 v6, 1, v1
    ds_write_b16 v6, v130 offset:7168
    ds_write_b16 v6, v131 offset:7296
    ds_write_b16 v6, v132 offset:7424
    s_branch L_po_done
L_po_ok1:
    v_readlane_b32 s72, v78, 0
    v_readlane_b32 s80, v79, 0
    v_readlane_b32 s73, v78, 1
    v_readlane_b32 s81, v79, 1
    v_readlane_b32 s74, v78, 2
    v_readlane_b32 s82, v79, 2
    v_readlane_b32 s75, v78, 3
    v_readlane_b32 s83, v79, 3
    v_readlane_b32 s76, v78, 4
    v_readlane_b32 s84, v79, 4
    v_readlane_b32 s77, v78, 5
    v_readlane_b32 s85, v79, 5
    v_readlane_b32 s78, v78, 6
    v_readlane_b32 s86, v79, 6
    v_readlane_b32 s79, v78, 7
    v_readlane_b32 s87, v79, 7
    s_nop 1
    v_mov_b32 v128, s72
    v_max_f32 v128, s73, v128
    v_max_f32 v128, s74, v128
    v_max_f32 v128, s75, v128
    v_max_f32 v128, s76, v128
    v_max_f32 v128, s77, v128
    v_max_f32 v128, s78, v128
    v_max_f32 v128, s79, v128
    v_sub_f32 v120, s72, v128
    v_sub_f32 v121, s73, v128
    v_sub_f32 v122, s74, v128
    v_sub_f32 v123, s75, v128
    v_sub_f32 v124, s76, v128
    v_sub_f32 v125, s77, v128
    v_sub_f32 v126, s78, v128
    v_sub_f32 v127, s79, v128
    v_mul_f32 v120, s14, v120
    v_mul_f32 v121, s14, v121
    v_mul_f32 v122, s14, v122
    v_mul_f32 v123, s14, v123
    v_mul_f32 v124, s14, v124
    v_mul_f32 v125, s14, v125
    v_mul_f32 v126, s14, v126
    v_mul_f32 v127, s14, v127
    v_exp_f32 v120, v120
    v_exp_f32 v121, v121
    v_exp_f32 v122, v122
    v_exp_f32 v123, v123
    v_exp_f32 v124, v124
    v_exp_f32 v125, v125
    v_exp_f32 v126, v126
    v_exp_f32 v127, v127
    s_nop 0
    v_mul_f32 v129, s80, v120
    v_fmac_f32 v129, s81, v121
    v_fmac_f32 v129, s82, v122
    v_fmac_f32 v129, s83, v123
    v_fmac_f32 v129, s84, v124
    v_fmac_f32 v129, s85, v125
    v_fmac_f32 v129, s86, v126
    v_fmac_f32 v129, s87, v127
    v_rcp_f32 v129, v129
    v_mul_f32 v130, v120, v46
    v_fmac_f32 v130, v121, v50
    v_fmac_f32 v130, v122, v54
    v_fmac_f32 v130, v123, v58
    v_fmac_f32 v130, v124, v62
    v_fmac_f32 v130, v125, v66
    v_fmac_f32 v130, v126, v70
    v_fmac_f32 v130, v127, v74
    v_mul_f32 v131, v120, v47
    v_fmac_f32 v131, v121, v51
    v_fmac_f32 v131, v122, v55
    v_fmac_f32 v131, v123, v59
    v_fmac_f32 v131, v124, v63
    v_fmac_f32 v131, v125, v67
    v_fmac_f32 v131, v126, v71
    v_fmac_f32 v131, v127, v75
    v_mul_f32 v132, v120, v48
    v_fmac_f32 v132, v121, v52
    v_fmac_f32 v132, v122, v56
    v_fmac_f32 v132, v123, v60
    v_fmac_f32 v132, v124, v64
    v_fmac_f32 v132, v125, v68
    v_fmac_f32 v132, v126, v72
    v_fmac_f32 v132, v127, v76
    v_mul_f32 v130, v130, v129
    v_cvt_pk_bf16_f32 v130, v130, v130
    v_mul_f32 v131, v131, v129
    v_cvt_pk_bf16_f32 v131, v131, v131
    v_mul_f32 v132, v132, v129
    v_cvt_pk_bf16_f32 v132, v132, v132
    v_lshlrev_b32 v6, 1, v1
    ds_write_b16 v6, v130 offset:7168
    ds_write_b16 v6, v131 offset:7296
    ds_write_b16 v6, v132 offset:7424
L_po_done:
    s_waitcnt lgkmcnt(0)
    s_barrier
    s_cmp_ge_u32 s4, 5
    s_cbranch_scc1 L_end
    s_mul_i32 s13, s5, 20480
    s_lshl_b32 s15, s4, 7
    s_add_u32 s13, s13, s15
    s_add_u32 s13, s13, 663552
    v_mul_u32_u24 v7, 640, v2
    v_lshl_add_u32 v7, v3, 3, v7
    s_add_u32 s72, s13, 0
    s_add_u32 s73, s13, 2560
    s_add_u32 s74, s13, 5120
    s_add_u32 s75, s13, 7680
    s_add_u32 s76, s13, 10240
    s_add_u32 s77, s13, 12800
    s_add_u32 s78, s13, 15360
    s_add_u32 s79, s13, 17920
    s_sleep 8
    buffer_load_dwordx2 v[10:11], v7, s[60:63], s72 offen sc1
    buffer_load_dwordx2 v[12:13], v7, s[60:63], s73 offen sc1
    buffer_load_dwordx2 v[14:15], v7, s[60:63], s74 offen sc1
    buffer_load_dwordx2 v[16:17], v7, s[60:63], s75 offen sc1
    buffer_load_dwordx2 v[18:19], v7, s[60:63], s76 offen sc1
    buffer_load_dwordx2 v[20:21], v7, s[60:63], s77 offen sc1
    buffer_load_dwordx2 v[22:23], v7, s[60:63], s78 offen sc1
    buffer_load_dwordx2 v[24:25], v7, s[60:63], s79 offen sc1
    s_sleep 12
    buffer_load_dwordx2 v[26:27], v7, s[60:63], s72 offen sc1
    buffer_load_dwordx2 v[28:29], v7, s[60:63], s73 offen sc1
    buffer_load_dwordx2 v[30:31], v7, s[60:63], s74 offen sc1
    buffer_load_dwordx2 v[32:33], v7, s[60:63], s75 offen sc1
    buffer_load_dwordx2 v[34:35], v7, s[60:63], s76 offen sc1
    buffer_load_dwordx2 v[36:37], v7, s[60:63], s77 offen sc1
    buffer_load_dwordx2 v[38:39], v7, s[60:63], s78 offen sc1
    buffer_load_dwordx2 v[40:41], v7, s[60:63], s79 offen sc1
    s_sleep 12
    buffer_load_dwordx2 v[42:43], v7, s[60:63], s72 offen sc1
    buffer_load_dwordx2 v[44:45], v7, s[60:63], s73 offen sc1
    buffer_load_dwordx2 v[46:47], v7, s[60:63], s74 offen sc1
    buffer_load_dwordx2 v[48:49], v7, s[60:63], s75 offen sc1
    buffer_load_dwordx2 v[50:51], v7, s[60:63], s76 offen sc1
    buffer_load_dwordx2 v[52:53], v7, s[60:63], s77 offen sc1
    buffer_load_dwordx2 v[54:55], v7, s[60:63], s78 offen sc1
    buffer_load_dwordx2 v[56:57], v7, s[60:63], s79 offen sc1
    s_sleep 12
    buffer_load_dwordx2 v[58:59], v7, s[60:63], s72 offen sc1
    buffer_load_dwordx2 v[60:61], v7, s[60:63], s73 offen sc1
    buffer_load_dwordx2 v[62:63], v7, s[60:63], s74 offen sc1
    buffer_load_dwordx2 v[64:65], v7, s[60:63], s75 offen sc1
    buffer_load_dwordx2 v[66:67], v7, s[60:63], s76 offen sc1
    buffer_load_dwordx2 v[68:69], v7, s[60:63], s77 offen sc1
    buffer_load_dwordx2 v[70:71], v7, s[60:63], s78 offen sc1
    buffer_load_dwordx2 v[72:73], v7, s[60:63], s79 offen sc1
    s_mov_b32 s69, 0
L_pf_tops:
    s_waitcnt vmcnt(24)
    v_xor_b32 v150, s96, v11
    v_xor_b32 v151, s96, v13
    v_or_b32 v150, v150, v151
    v_xor_b32 v151, s96, v15
    v_or_b32 v150, v150, v151
    v_xor_b32 v151, s96, v17
    v_or_b32 v150, v150, v151
    v_xor_b32 v151, s96, v19
    v_or_b32 v150, v150, v151
    v_xor_b32 v151, s96, v21
    v_or_b32 v150, v150, v151
    v_xor_b32 v151, s96, v23
    v_or_b32 v150, v150, v151
    v_xor_b32 v151, s96, v25
    v_or_b32 v150, v150, v151
    v_cmp_ne_u32 vcc, 0, v150
    s_cbranch_vccz L_pf_ok0
    s_add_u32 s69, s69, 1
    buffer_load_dwordx2 v[10:11], v7, s[60:63], s72 offen sc1
    buffer_load_dwordx2 v[12:13], v7, s[60:63], s73 offen sc1
    buffer_load_dwordx2 v[14:15], v7, s[60:63], s74 offen sc1
    buffer_load_dwordx2 v[16:17], v7, s[60:63], s75 offen sc1
    buffer_load_dwordx2 v[18:19], v7, s[60:63], s76 offen sc1
    buffer_load_dwordx2 v[20:21], v7, s[60:63], s77 offen sc1
    buffer_load_dwordx2 v[22:23], v7, s[60:63], s78 offen sc1
    buffer_load_dwordx2 v[24:25], v7, s[60:63], s79 offen sc1
    s_waitcnt vmcnt(24)
    v_xor_b32 v150, s96, v27
    v_xor_b32 v151, s96, v29
    v_or_b32 v150, v150, v151
    v_xor_b32 v151, s96, v31
    v_or_b32 v150, v150, v151
    v_xor_b32 v151, s96, v33
    v_or_b32 v150, v150, v151
    v_xor_b32 v151, s96, v35
    v_or_b32 v150, v150, v151
    v_xor_b32 v151, s96, v37
    v_or_b32 v150, v150, v151
    v_xor_b32 v151, s96, v39
    v_or_b32 v150, v150, v151
    v_xor_b32 v151, s96, v41
    v_or_b32 v150, v150, v151
    v_cmp_ne_u32 vcc, 0, v150
    s_cbranch_vccz L_pf_ok1
    s_add_u32 s69, s69, 1
    buffer_load_dwordx2 v[26:27], v7, s[60:63], s72 offen sc1
    buffer_load_dwordx2 v[28:29], v7, s[60:63], s73 offen sc1
    buffer_load_dwordx2 v[30:31], v7, s[60:63], s74 offen sc1
    buffer_load_dwordx2 v[32:33], v7, s[60:63], s75 offen sc1
    buffer_load_dwordx2 v[34:35], v7, s[60:63], s76 offen sc1
    buffer_load_dwordx2 v[36:37], v7, s[60:63], s77 offen sc1
    buffer_load_dwordx2 v[38:39], v7, s[60:63], s78 offen sc1
    buffer_load_dwordx2 v[40:41], v7, s[60:63], s79 offen sc1
    s_waitcnt vmcnt(24)
    v_xor_b32 v150, s96, v43
    v_xor_b32 v151, s96, v45
    v_or_b32 v150, v150, v151
    v_xor_b32 v151, s96, v47
    v_or_b32 v150, v150, v151
    v_xor_b32 v151, s96, v49
    v_or_b32 v150, v150, v151
    v_xor_b32 v151, s96, v51
    v_or_b32 v150, v150, v151
    v_xor_b32 v151, s96, v53
    v_or_b32 v150, v150, v151
    v_xor_b32 v151, s96, v55
    v_or_b32 v150, v150, v151
    v_xor_b32 v151, s96, v57
    v_or_b32 v150, v150, v151
    v_cmp_ne_u32 vcc, 0, v150
    s_cbranch_vccz L_pf_ok2
    s_add_u32 s69, s69, 1
    buffer_load_dwordx2 v[42:43], v7, s[60:63], s72 offen sc1
    buffer_load_dwordx2 v[44:45], v7, s[60:63], s73 offen sc1
    buffer_load_dwordx2 v[46:47], v7, s[60:63], s74 offen sc1
    buffer_load_dwordx2 v[48:49], v7, s[60:63], s75 offen sc1
    buffer_load_dwordx2 v[50:51], v7, s[60:63], s76 offen sc1
    buffer_load_dwordx2 v[52:53], v7, s[60:63], s77 offen sc1
    buffer_load_dwordx2 v[54:55], v7, s[60:63], s78 offen sc1
    buffer_load_dwordx2 v[56:57], v7, s[60:63], s79 offen sc1
    s_waitcnt vmcnt(24)
    v_xor_b32 v150, s96, v59
    v_xor_b32 v151, s96, v61
    v_or_b32 v150, v150, v151
    v_xor_b32 v151, s96, v63
    v_or_b32 v150, v150, v151
    v_xor_b32 v151, s96, v65
    v_or_b32 v150, v150, v151
    v_xor_b32 v151, s96, v67
    v_or_b32 v150, v150, v151
    v_xor_b32 v151, s96, v69
    v_or_b32 v150, v150, v151
    v_xor_b32 v151, s96, v71
    v_or_b32 v150, v150, v151
    v_xor_b32 v151, s96, v73
    v_or_b32 v150, v150, v151
    v_cmp_ne_u32 vcc, 0, v150
    s_cbranch_vccz L_pf_ok3
    s_add_u32 s69, s69, 1
    buffer_load_dwordx2 v[58:59], v7, s[60:63], s72 offen sc1
    buffer_load_dwordx2 v[60:61], v7, s[60:63], s73 offen sc1
    buffer_load_dwordx2 v[62:63], v7, s[60:63], s74 offen sc1
    buffer_load_dwordx2 v[64:65], v7, s[60:63], s75 offen sc1
    buffer_load_dwordx2 v[66:67], v7, s[60:63], s76 offen sc1
    buffer_load_dwordx2 v[68:69], v7, s[60:63], s77 offen sc1
    buffer_load_dwordx2 v[70:71], v7, s[60:63], s78 offen sc1
    buffer_load_dwordx2 v[72:73], v7, s[60:63], s79 offen sc1
    s_cmp_lt_u32 s69, 100000
    s_cbranch_scc1 L_pf_tops
    s_waitcnt vmcnt(0)
L_pf_ok0:
    v_add_f32 v120, v10, v12
    v_add_f32 v120, v120, v14
    v_add_f32 v120, v120, v16
    v_add_f32 v120, v120, v18
    v_add_f32 v120, v120, v20
    v_add_f32 v120, v120, v22
    v_add_f32 v120, v120, v24
    s_branch L_pf_done
L_pf_ok1:
    v_add_f32 v120, v26, v28
    v_add_f32 v120, v120, v30
    v_add_f32 v120, v120, v32
    v_add_f32 v120, v120, v34
    v_add_f32 v120, v120, v36
    v_add_f32 v120, v120, v38
    v_add_f32 v120, v120, v40
    s_branch L_pf_done
L_pf_ok2:
    v_add_f32 v120, v42, v44
    v_add_f32 v120, v120, v46
    v_add_f32 v120, v120, v48
    v_add_f32 v120, v120, v50
    v_add_f32 v120, v120, v52
    v_add_f32 v120, v120, v54
    v_add_f32 v120, v120, v56
    s_branch L_pf_done
L_pf_ok3:
    v_add_f32 v120, v58, v60
    v_add_f32 v120, v120, v62
    v_add_f32 v120, v120, v64
    v_add_f32 v120, v120, v66
    v_add_f32 v120, v120, v68
    v_add_f32 v120, v120, v70
    v_add_f32 v120, v120, v72
L_pf_done:
    v_mov_b32 v121, v120
    s_nop 1
    v_permlane32_swap_b32 v120, v121
    v_add_f32 v120, v120, v121
    v_mov_b32 v121, v120
    s_nop 1
    v_permlane16_swap_b32 v120, v121
    v_add_f32 v120, v120, v121
    v_cvt_pk_bf16_f32 v120, v120, v120
    s_mul_i32 s13, s5, 160
    s_lshl_b32 s15, s4, 5
    s_add_u32 s13, s13, s15
    v_lshlrev_b32 v7, 1, v3
    s_mov_b64 exec, 0xffff
    buffer_store_short v120, v7, s[52:55], s13 offen
    s_cmp_lg_u32 s9, 0
    s_cbranch_scc1 L_noepoch
    v_mov_b32 v6, s96
    s_mov_b32 s13, 0xf0000
    s_mov_b64 exec, 1
    buffer_store_dword v6, v5, s[60:63], s13 offen sc1
L_noepoch:
L_end:
    s_endpgm
.section .rodata,"a"
.p2align 6
.amdhsa_kernel standalone__sliding_block_cached__decode_kernel
  .amdhsa_next_free_vgpr 168
  .amdhsa_next_free_sgpr 100
  .amdhsa_accum_offset 168
  .amdhsa_group_segment_fixed_size 0
  .amdhsa_kernarg_size 64
  .amdhsa_user_sgpr_count 2
  .amdhsa_user_sgpr_kernarg_segment_ptr 1
  .amdhsa_system_sgpr_workgroup_id_x 1
.end_amdhsa_kernel
```
